```python
import torch

def _softmax(x, axis=-1):
    return torch.softmax(x, dim=axis)
def _gelu(x):
    return torch.nn.functional.gelu(x, approximate="tanh")
def _silu(x):
    return torch.nn.functional.silu(x)
def _sigmoid(x):
    return torch.sigmoid(x)
def _layernorm(x, axis=-1, eps=1e-5):
    m = x.mean(dim=axis, keepdim=True)
    v = x.var(dim=axis, keepdim=True, unbiased=False)
    return (x - m) / torch.sqrt(v + eps)
def _scatter_add(tgt, idx, src, axis=0):
    return tgt.clone().index_add_(axis, idx, src)
def _segment_sum(src, seg, n):
    out = torch.zeros((n,) + src.shape[1:], dtype=src.dtype)
    return out.index_add_(0, seg, src)
def _pad(x, pw):
    flat = tuple(v for pair in reversed(pw) for v in pair)
    return torch.nn.functional.pad(x, flat)

kernel_name = 'standalone__rezero__sampling'

def setup_inputs():

    _w = (lambda a: (lambda t: t.to(torch.bfloat16) if t.is_floating_point() else t)(torch.as_tensor(a)))
    B, S, D = 1024, 16, 448
    return {
        "x": _w((lambda *s: torch.randn(*s, dtype=torch.bfloat16) * 0.05)(B, S, D)),
        "fx": _w((lambda *s: torch.randn(*s, dtype=torch.bfloat16) * 0.8)(B, S, D)),
        "alpha": _w((lambda *s: torch.randn(*s, dtype=torch.bfloat16) * 0.8)(1) * 0.1),
    }

def reference(x, fx, alpha):
    return x + alpha * fx
```

```asm
; @launch grid=(1792,1,1) block=(256,1,1) lds=0
.amdgcn_target "amdgcn-amd-amdhsa--gfx950"
.text
.globl standalone__rezero__sampling_kernel
.p2align 8
.type standalone__rezero__sampling_kernel,@function

.macro REZ f, x, a0, a1, b0, b1
    v_lshlrev_b32 v\a0, 16, v\f
    v_and_b32 v\a1, s14, v\f
    v_pk_mul_f32 v[\a0:\a1], v[\a0:\a1], s[12:13]
    v_lshlrev_b32 v\b0, 16, v\x
    v_and_b32 v\b1, s14, v\x
    v_cvt_pk_bf16_f32 v\f, v\a0, v\a1
    v_lshlrev_b32 v\a0, 16, v\f
    v_and_b32 v\a1, s14, v\f
    v_pk_add_f32 v[\b0:\b1], v[\b0:\b1], v[\a0:\a1]
    v_cvt_pk_bf16_f32 v\x, v\b0, v\b1
.endm

standalone__rezero__sampling_kernel:
    s_load_dwordx8 s[4:11], s[0:1], 0
    s_cmpk_ge_u32 s2, 1792
    s_cbranch_scc1 L_done
    s_lshl_b32 s3, s2, 13
    v_and_b32 v1, 0xc0, v0
    v_add_lshl_u32 v0, v0, v1, 4
    v_add_u32 v0, s3, v0
    s_mov_b32 s14, 0xffff0000
    s_waitcnt lgkmcnt(0)
    global_load_dwordx4 v[6:9], v0, s[6:7] nt
    global_load_dwordx4 v[2:5], v0, s[4:5] nt
    s_load_dword s12, s[8:9], 0
    global_load_dwordx4 v[14:17], v0, s[6:7] offset:1024 nt
    global_load_dwordx4 v[10:13], v0, s[4:5] offset:1024 nt
    s_waitcnt lgkmcnt(0)
    s_lshl_b32 s12, s12, 16
    s_mov_b32 s13, s12
    s_waitcnt vmcnt(2)
    REZ 6, 2, 18, 19, 20, 21
    REZ 7, 3, 22, 23, 24, 25
    REZ 8, 4, 18, 19, 20, 21
    REZ 9, 5, 22, 23, 24, 25
    global_store_dwordx4 v0, v[2:5], s[10:11]
    s_waitcnt vmcnt(1)
    REZ 14, 10, 18, 19, 20, 21
    REZ 15, 11, 22, 23, 24, 25
    REZ 16, 12, 18, 19, 20, 21
    REZ 17, 13, 22, 23, 24, 25
    global_store_dwordx4 v0, v[10:13], s[10:11] offset:1024
L_done:
    s_endpgm
.section .rodata,"a"
.p2align 6
.amdhsa_kernel standalone__rezero__sampling_kernel
  .amdhsa_next_free_vgpr 26
  .amdhsa_next_free_sgpr 16
  .amdhsa_accum_offset 28
  .amdhsa_group_segment_fixed_size 0
  .amdhsa_kernarg_size 48
  .amdhsa_user_sgpr_count 2
  .amdhsa_user_sgpr_kernarg_segment_ptr 1
  .amdhsa_system_sgpr_workgroup_id_x 1
  .amdhsa_float_denorm_mode_32 3
.end_amdhsa_kernel
```
